```python
import torch

def _softmax(x, axis=-1):
    return torch.softmax(x, dim=axis)
def _gelu(x):
    return torch.nn.functional.gelu(x, approximate="tanh")
def _silu(x):
    return torch.nn.functional.silu(x)
def _sigmoid(x):
    return torch.sigmoid(x)
def _layernorm(x, axis=-1, eps=1e-5):
    m = x.mean(dim=axis, keepdim=True)
    v = x.var(dim=axis, keepdim=True, unbiased=False)
    return (x - m) / torch.sqrt(v + eps)
def _scatter_add(tgt, idx, src, axis=0):
    return tgt.clone().index_add_(axis, idx, src)
def _segment_sum(src, seg, n):
    out = torch.zeros((n,) + src.shape[1:], dtype=src.dtype)
    return out.index_add_(0, seg, src)
def _pad(x, pw):
    flat = tuple(v for pair in reversed(pw) for v in pair)
    return torch.nn.functional.pad(x, flat)

kernel_name = 'standalone__sliding_block_cached__decode'

def setup_inputs():

    _w = (lambda a: (lambda t: t.to(torch.bfloat16) if t.is_floating_point() else t)(torch.as_tensor(a)))
    B, Sq, D = 8, 1, 512
    Hq, Hkv, Sk, Dh = 32, 8, 4096, 128
    assert Hq % Hkv == 0, (Hq, Hkv)
    return {
        "x": _w((lambda *s: torch.randn(*s, dtype=torch.bfloat16) * 0.8)(B, Sq, D)),
        "k_cache": _w((lambda *s: torch.randn(*s, dtype=torch.bfloat16) * 0.8)(B, Hkv, Sk, Dh)),
        "v_cache": _w((lambda *s: torch.randn(*s, dtype=torch.bfloat16) * 0.05)(B, Hkv, Sk, Dh)),
        "wq": _w((lambda *s: torch.randn(*s, dtype=torch.bfloat16) * 0.8)(D, Hq * Dh) * (D ** -0.5)),
        "wo": _w((lambda *s: torch.randn(*s, dtype=torch.bfloat16) * 0.05)(Hq * Dh, D) * ((Hq * Dh) ** -0.5)),
    }

def reference(x, k_cache, v_cache, wq, wo):
    B, Sq, D = x.shape
    Hq, Dh = 32, 128
    Hkv, Sk = k_cache.shape[1], k_cache.shape[2]
    W = min(4096, max(256, Sk // 4))
    rep = Hq // Hkv
    q = (lambda x, *d: x.permute(*d))((x @ wq).reshape(B, Sq, Hq, Dh), 0, 2, 1, 3)
    k = (lambda x, n, axis: torch.repeat_interleave(x, n, dim=axis))(k_cache[:, :, Sk - W:, :], rep, axis=1)
    v = (lambda x, n, axis: torch.repeat_interleave(x, n, dim=axis))(v_cache[:, :, Sk - W:, :], rep, axis=1)
    scores = torch.einsum("bhqd,bhkd->bhqk", q, k) * (Dh ** -0.5)
    p = _softmax(scores, axis=-1)
    o = torch.einsum("bhqk,bhkd->bhqd", p, v)
    return (lambda x, *d: x.permute(*d))(o, 0, 2, 1, 3).reshape(B, Sq, Hq * Dh) @ wo
```

```asm
; @launch grid=(256,1,1) block=(320,1,1) lds=42368
.amdgcn_target "amdgcn-amd-amdhsa--gfx950"
.text
.globl standalone__sliding_block_cached__decode_kernel
.p2align 8
.type standalone__sliding_block_cached__decode_kernel,@function
standalone__sliding_block_cached__decode_kernel:
s_load_dwordx16 s[4:19], s[0:1], 0
s_cmpk_ge_u32 s2, 0x100
s_cbranch_scc1 L_end
v_lshrrev_b32 v1, 6, v0
v_and_b32 v0, 63, v0
s_and_b32 s20, s2, 7
v_readfirstlane_b32 s24, v1
s_lshr_b32 s21, s2, 3
v_and_b32 v1, 15, v0
v_lshrrev_b32 v2, 4, v0
s_lshr_b32 s22, s21, 2
s_lshr_b32 s27, s21, 3
s_and_b32 s28, s21, 7
s_cmp_eq_u32 s24, 0
s_cbranch_scc1 L_sync
s_sub_u32 s26, s24, 1
v_lshrrev_b32 v6, 3, v0
v_and_b32 v12, 7, v0
v_lshlrev_b32 v7, 4, v12
v_lshl_add_u32 v8, v6, 13, v7
s_lshl_b32 s34, s20, 10
s_lshl_b32 s29, s28, 7
s_add_u32 s34, s34, s29
s_lshl_b32 s29, s27, 20
s_add_u32 s34, s34, s29
s_lshl_b32 s29, s26, 18
s_add_u32 s34, s34, s29
s_lshl_b32 m0, s26, 12
s_mov_b32 s53, 0xfc00
s_and_b32 s23, s21, 3
s_lshl_b32 s29, s22, 3
s_add_u32 s29, s29, s20
s_lshl_b32 s29, s29, 20
s_lshl_b32 s30, s23, 16
s_add_u32 s29, s29, s30
s_lshl_b32 s30, s26, 14
s_add_u32 s29, s29, s30
s_add_u32 s29, s29, 786432
s_and_b32 s30, s26, 1
s_lshl_b32 s30, s30, 1
s_add_u32 s30, s30, s22
s_and_b32 s30, s30, 3
s_lshl_b32 s30, s30, 12
s_add_u32 s29, s29, s30
v_and_b32 v3, 3, v1
v_lshlrev_b32 v3, 10, v3
v_bfe_u32 v4, v1, 2, 1
v_lshl_add_u32 v3, v4, 8, v3
v_lshl_add_u32 v3, v2, 4, v3
v_lshrrev_b32 v13, 3, v1
v_lshlrev_b32 v4, 6, v13
v_sub_u32 v5, v3, v4
v_add_u32 v5, 0x240, v5
v_add_u32 v3, v3, v4
s_waitcnt lgkmcnt(0)
s_add_u32 s34, s10, s34
s_addc_u32 s35, s11, 0
global_load_lds_dwordx4 v8, s[34:35] offset:0 nt
v_add_u32 v8, s53, v8
global_load_lds_dwordx4 v8, s[34:35] offset:1024 nt
v_add_u32 v8, s53, v8
global_load_lds_dwordx4 v8, s[34:35] offset:2048 nt
v_add_u32 v8, s53, v8
global_load_lds_dwordx4 v8, s[34:35] offset:3072 nt
s_add_u32 s30, s6, s29
s_addc_u32 s31, s7, 0
global_load_dwordx4 v[16:19], v3, s[30:31] offset:0 nt
global_load_dwordx4 v[20:23], v5, s[30:31] offset:0 nt
s_load_dword s25, s[18:19], 0
s_add_u32 s32, s8, s29
s_addc_u32 s33, s9, 0
v_lshlrev_b32 v4, 4, v0
s_mov_b32 s40, 0xff00ff00
s_mov_b32 s41, 0xff00ff00
v_lshl_add_u32 v6, v6, 10, v7
s_lshl_b32 s34, s20, 19
s_lshl_b32 s35, s27, 17
s_add_u32 s34, s34, s35
s_lshl_b32 s35, s28, 7
s_add_u32 s34, s34, s35
s_lshl_b32 s35, s26, 15
s_add_u32 s34, s34, s35
s_add_u32 s34, s12, s34
s_addc_u32 s35, s13, 0
s_and_b32 s53, s21, 3
s_lshl_b32 s52, s53, 10
s_add_u32 s52, s52, 16384
s_add_u32 m0, m0, s52
v_lshl_add_u32 v6, s53, 13, v6
v_lshrrev_b32 v15, 2, v1
v_lshlrev_b32 v7, 8, v15
v_lshl_add_u32 v7, v2, 4, v7
s_lshl_b32 s39, s26, 3
v_lshl_add_u32 v10, v15, 5, s39
s_mov_b32 s36, 1040356334
s_mov_b32 s37, 0x05040100
s_mov_b32 s38, 0x07060302
s_lshl_b32 s39, s26, 11
s_add_u32 s43, s39, 32768
v_lshl_add_u32 v240, v0, 2, s43
v_add_u32 v241, 16, v0
v_and_b32 v241, 63, v241
v_lshl_add_u32 v241, v241, 2, s43
v_add_u32 v242, 32, v0
v_and_b32 v242, 63, v242
v_lshl_add_u32 v242, v242, 2, s43
v_add_u32 v243, 48, v0
v_and_b32 v243, 63, v243
v_lshl_add_u32 v243, v243, 2, s43
v_lshlrev_b32 v14, 4, v12
v_lshl_add_u32 v244, v13, 2, v14
v_add_u32 v244, 42112, v244
v_and_b32 v11, 1, v2
s_lshl_b32 s43, s26, 1
v_lshl_add_u32 v14, v2, 12, v14
s_lshl_b32 s46, s20, 15
s_lshl_b32 s47, s27, 13
s_add_u32 s46, s46, s47
s_add_u32 s46, s46, s39
v_lshl_add_u32 v15, v11, 3, s43
v_xor_b32 v15, v15, v1
v_lshl_add_u32 v245, v2, 8, s39
v_xor_b32 v246, 1, v15
v_lshl_add_u32 v246, v246, 4, v245
v_lshl_add_u32 v245, v15, 4, v245
v_lshlrev_b32 v15, 10, v12
v_lshl_add_u32 v15, v13, 8, v15
v_xor_b32 v9, v2, v1
v_xor_b32 v247, 0, v9
v_lshl_add_u32 v247, v247, 4, v15
v_xor_b32 v248, 4, v9
v_lshl_add_u32 v248, v248, 4, v15
v_xor_b32 v249, 8, v9
v_lshl_add_u32 v249, v249, 4, v15
v_xor_b32 v250, 12, v9
v_lshl_add_u32 v250, v250, 4, v15
s_add_u32 s46, s46, 262144
s_add_u32 s46, s18, s46
s_addc_u32 s47, s19, 0
v_lshlrev_b32 v11, 5, v11
v_lshrrev_b32 v15, 1, v2
v_lshl_add_u32 v11, v15, 1, v11
v_lshl_add_u32 v11, v13, 3, v11
v_bfe_u32 v15, v1, 2, 1
v_add_u32 v11, v11, v15
v_lshlrev_b32 v11, 7, v11
v_and_b32 v15, 3, v1
v_lshl_add_u32 v11, v15, 3, v11
s_lshl_b32 s39, s26, 5
v_add_u32 v11, s39, v11
s_lshl_b32 s48, s28, 16
s_lshl_b32 s49, s26, 14
s_add_u32 s48, s48, s49
s_lshl_b32 s49, s20, 9
s_add_u32 s48, s48, s49
s_lshl_b32 s49, s27, 7
s_add_u32 s48, s48, s49
s_add_u32 s48, s48, 1048576
s_add_u32 s48, s18, s48
s_addc_u32 s49, s19, 0
s_movk_i32 s42, 0xff
s_not_b64 s[44:45], s[40:41]
s_waitcnt vmcnt(5)
global_load_dwordx4 v[24:27], v3, s[30:31] offset:128 nt
s_waitcnt vmcnt(5)
global_load_dwordx4 v[28:31], v5, s[30:31] offset:128 nt
s_xor_b32 s52, s29, 4096
s_add_u32 s30, s6, s52
s_addc_u32 s31, s7, 0
s_waitcnt vmcnt(5)
global_load_dwordx4 v[32:35], v3, s[30:31] offset:0 nt
s_waitcnt vmcnt(5)
global_load_dwordx4 v[36:39], v5, s[30:31] offset:0 nt
s_barrier
s_waitcnt lgkmcnt(0)
s_add_u32 s51, s25, 1
s_mul_i32 s25, s25, 0x9E3779B1
s_add_u32 s25, s25, 0x7F4A7C15
s_andn2_b32 s25, s25, 0xff
s_and_b32 s56, s51, 0xff
s_or_b32 s25, s25, s56
s_lshr_b32 s56, s25, 8
s_lshr_b32 s57, s25, 16
s_lshr_b32 s58, s25, 24
v_mov_b32 v252, s25
v_mov_b32 v253, s56
v_mov_b32 v254, s57
v_mov_b32 v255, s58
s_waitcnt vmcnt(5)
global_load_dwordx4 v[40:43], v3, s[30:31] offset:128 nt
s_waitcnt vmcnt(5)
global_load_dwordx4 v[44:47], v5, s[30:31] offset:128 nt
s_xor_b32 s52, s29, 8192
s_add_u32 s30, s6, s52
s_addc_u32 s31, s7, 0
s_waitcnt vmcnt(5)
global_load_dwordx4 v[48:51], v3, s[30:31] offset:0 nt
s_waitcnt vmcnt(5)
global_load_dwordx4 v[52:55], v5, s[30:31] offset:0 nt
s_mov_b64 exec, s[40:41]
v_swap_b32 v16, v20
v_swap_b32 v17, v21
v_swap_b32 v18, v22
v_swap_b32 v19, v23
v_swap_b32 v24, v28
v_swap_b32 v25, v29
v_swap_b32 v26, v30
v_swap_b32 v27, v31
s_mov_b64 exec, -1
v_mov_b32_dpp v20, v20 row_ror:8 row_mask:0xf bank_mask:0xf
v_mov_b32_dpp v21, v21 row_ror:8 row_mask:0xf bank_mask:0xf
v_mov_b32_dpp v22, v22 row_ror:8 row_mask:0xf bank_mask:0xf
v_mov_b32_dpp v23, v23 row_ror:8 row_mask:0xf bank_mask:0xf
v_mov_b32_dpp v28, v28 row_ror:8 row_mask:0xf bank_mask:0xf
v_mov_b32_dpp v29, v29 row_ror:8 row_mask:0xf bank_mask:0xf
v_mov_b32_dpp v30, v30 row_ror:8 row_mask:0xf bank_mask:0xf
v_mov_b32_dpp v31, v31 row_ror:8 row_mask:0xf bank_mask:0xf
s_waitcnt vmcnt(5)
global_load_dwordx4 v[56:59], v3, s[30:31] offset:128 nt
s_waitcnt vmcnt(5)
global_load_dwordx4 v[60:63], v5, s[30:31] offset:128 nt
s_xor_b32 s52, s29, 12288
s_add_u32 s30, s6, s52
s_addc_u32 s31, s7, 0
s_waitcnt vmcnt(5)
global_load_dwordx4 v[64:67], v3, s[30:31] offset:0 nt
s_waitcnt vmcnt(5)
global_load_dwordx4 v[68:71], v5, s[30:31] offset:0 nt
s_mov_b64 exec, s[40:41]
v_swap_b32 v32, v36
v_swap_b32 v33, v37
v_swap_b32 v34, v38
v_swap_b32 v35, v39
v_swap_b32 v40, v44
v_swap_b32 v41, v45
v_swap_b32 v42, v46
v_swap_b32 v43, v47
s_mov_b64 exec, -1
v_mov_b32_dpp v36, v36 row_ror:8 row_mask:0xf bank_mask:0xf
v_mov_b32_dpp v37, v37 row_ror:8 row_mask:0xf bank_mask:0xf
v_mov_b32_dpp v38, v38 row_ror:8 row_mask:0xf bank_mask:0xf
v_mov_b32_dpp v39, v39 row_ror:8 row_mask:0xf bank_mask:0xf
v_mov_b32_dpp v44, v44 row_ror:8 row_mask:0xf bank_mask:0xf
v_mov_b32_dpp v45, v45 row_ror:8 row_mask:0xf bank_mask:0xf
v_mov_b32_dpp v46, v46 row_ror:8 row_mask:0xf bank_mask:0xf
v_mov_b32_dpp v47, v47 row_ror:8 row_mask:0xf bank_mask:0xf
s_waitcnt vmcnt(5)
global_load_dwordx4 v[72:75], v3, s[30:31] offset:128 nt
s_waitcnt vmcnt(5)
global_load_dwordx4 v[76:79], v5, s[30:31] offset:128 nt
s_waitcnt vmcnt(5)
global_load_dwordx4 v[80:83], v4, s[32:33] offset:0 nt
s_waitcnt vmcnt(5)
global_load_dwordx4 v[84:87], v4, s[32:33] offset:1024 nt
s_mov_b64 exec, s[40:41]
v_swap_b32 v48, v52
v_swap_b32 v49, v53
v_swap_b32 v50, v54
v_swap_b32 v51, v55
v_swap_b32 v56, v60
v_swap_b32 v57, v61
v_swap_b32 v58, v62
v_swap_b32 v59, v63
s_mov_b64 exec, -1
v_mov_b32_dpp v52, v52 row_ror:8 row_mask:0xf bank_mask:0xf
v_mov_b32_dpp v53, v53 row_ror:8 row_mask:0xf bank_mask:0xf
v_mov_b32_dpp v54, v54 row_ror:8 row_mask:0xf bank_mask:0xf
v_mov_b32_dpp v55, v55 row_ror:8 row_mask:0xf bank_mask:0xf
v_mov_b32_dpp v60, v60 row_ror:8 row_mask:0xf bank_mask:0xf
v_mov_b32_dpp v61, v61 row_ror:8 row_mask:0xf bank_mask:0xf
v_mov_b32_dpp v62, v62 row_ror:8 row_mask:0xf bank_mask:0xf
v_mov_b32_dpp v63, v63 row_ror:8 row_mask:0xf bank_mask:0xf
s_waitcnt vmcnt(5)
global_load_dwordx4 v[88:91], v4, s[32:33] offset:2048 nt
s_barrier
s_waitcnt vmcnt(5)
global_load_dwordx4 v[92:95], v4, s[32:33] offset:3072 nt
s_xor_b32 s52, s29, 4096
s_add_u32 s32, s8, s52
s_addc_u32 s33, s9, 0
s_waitcnt vmcnt(5)
global_load_dwordx4 v[96:99], v4, s[32:33] offset:0 nt
s_waitcnt vmcnt(5)
global_load_dwordx4 v[100:103], v4, s[32:33] offset:1024 nt
s_mov_b64 exec, s[40:41]
v_swap_b32 v64, v68
v_swap_b32 v65, v69
v_swap_b32 v66, v70
v_swap_b32 v67, v71
v_swap_b32 v72, v76
v_swap_b32 v73, v77
v_swap_b32 v74, v78
v_swap_b32 v75, v79
s_mov_b64 exec, -1
v_mov_b32_dpp v68, v68 row_ror:8 row_mask:0xf bank_mask:0xf
v_mov_b32_dpp v69, v69 row_ror:8 row_mask:0xf bank_mask:0xf
v_mov_b32_dpp v70, v70 row_ror:8 row_mask:0xf bank_mask:0xf
v_mov_b32_dpp v71, v71 row_ror:8 row_mask:0xf bank_mask:0xf
v_mov_b32_dpp v76, v76 row_ror:8 row_mask:0xf bank_mask:0xf
v_mov_b32_dpp v77, v77 row_ror:8 row_mask:0xf bank_mask:0xf
v_mov_b32_dpp v78, v78 row_ror:8 row_mask:0xf bank_mask:0xf
v_mov_b32_dpp v79, v79 row_ror:8 row_mask:0xf bank_mask:0xf
s_waitcnt vmcnt(5)
global_load_dwordx4 v[104:107], v4, s[32:33] offset:2048 nt
s_waitcnt vmcnt(5)
global_load_dwordx4 v[108:111], v4, s[32:33] offset:3072 nt
s_xor_b32 s52, s29, 8192
s_add_u32 s32, s8, s52
s_addc_u32 s33, s9, 0
global_load_dwordx4 v[112:115], v4, s[32:33] offset:0 nt
s_waitcnt vmcnt(6)
global_load_dwordx4 v[116:119], v4, s[32:33] offset:1024 nt
s_waitcnt vmcnt(6)
global_load_dwordx4 v[120:123], v4, s[32:33] offset:2048 nt
s_waitcnt vmcnt(6)
global_load_dwordx4 v[124:127], v4, s[32:33] offset:3072 nt
s_xor_b32 s52, s29, 12288
s_add_u32 s32, s8, s52
s_addc_u32 s33, s9, 0
s_waitcnt vmcnt(6)
global_load_dwordx4 v[128:131], v4, s[32:33] offset:0 nt
s_waitcnt vmcnt(6)
global_load_dwordx4 v[132:135], v4, s[32:33] offset:1024 nt
s_waitcnt vmcnt(6)
global_load_dwordx4 v[136:139], v4, s[32:33] offset:2048 nt
s_waitcnt vmcnt(6)
global_load_dwordx4 v[140:143], v4, s[32:33] offset:3072 nt
s_waitcnt vmcnt(14)
v_perm_b32 v208, v84, v80, s37
v_perm_b32 v212, v84, v80, s38
v_perm_b32 v216, v85, v81, s37
v_perm_b32 v220, v85, v81, s38
v_perm_b32 v224, v86, v82, s37
v_perm_b32 v228, v86, v82, s38
v_perm_b32 v232, v87, v83, s37
v_perm_b32 v236, v87, v83, s38
s_waitcnt vmcnt(12)
v_perm_b32 v209, v92, v88, s37
v_perm_b32 v213, v92, v88, s38
v_perm_b32 v217, v93, v89, s37
v_perm_b32 v221, v93, v89, s38
v_perm_b32 v225, v94, v90, s37
v_perm_b32 v229, v94, v90, s38
v_perm_b32 v233, v95, v91, s37
v_perm_b32 v237, v95, v91, s38
s_waitcnt vmcnt(10)
v_perm_b32 v210, v100, v96, s37
v_perm_b32 v214, v100, v96, s38
v_perm_b32 v218, v101, v97, s37
v_perm_b32 v222, v101, v97, s38
v_perm_b32 v226, v102, v98, s37
v_perm_b32 v230, v102, v98, s38
v_perm_b32 v234, v103, v99, s37
v_perm_b32 v238, v103, v99, s38
s_waitcnt vmcnt(8)
v_perm_b32 v211, v108, v104, s37
v_perm_b32 v215, v108, v104, s38
v_perm_b32 v219, v109, v105, s37
v_perm_b32 v223, v109, v105, s38
v_perm_b32 v227, v110, v106, s37
v_perm_b32 v231, v110, v106, s38
v_perm_b32 v235, v111, v107, s37
v_perm_b32 v239, v111, v107, s38
s_waitcnt vmcnt(6)
global_load_lds_dwordx4 v6, s[34:35] nt
s_xor_b32 m0, m0, 1024
v_xor_b32 v6, 8192, v6
s_nop 0
global_load_lds_dwordx4 v6, s[34:35] nt
s_xor_b32 m0, m0, 3072
v_xor_b32 v6, 24576, v6
s_nop 0
global_load_lds_dwordx4 v6, s[34:35] nt
s_xor_b32 m0, m0, 1024
v_xor_b32 v6, 8192, v6
s_nop 0
global_load_lds_dwordx4 v6, s[34:35] nt
v_perm_b32 v80, v116, v112, s37
v_perm_b32 v84, v116, v112, s38
v_perm_b32 v88, v117, v113, s37
v_perm_b32 v92, v117, v113, s38
v_perm_b32 v96, v118, v114, s37
v_perm_b32 v100, v118, v114, s38
v_perm_b32 v104, v119, v115, s37
v_perm_b32 v108, v119, v115, s38
s_barrier
ds_read_b128 v[144:147], v7 offset:40960
ds_read_b128 v[148:151], v7 offset:41024
ds_read_b128 v[152:155], v7 offset:41088
ds_read_b128 v[156:159], v7 offset:41152
s_waitcnt lgkmcnt(3)
v_mfma_f32_16x16x32_bf16 v[160:163], v[16:19], v[144:147], 0
v_mfma_f32_16x16x32_bf16 v[164:167], v[32:35], v[144:147], 0
v_mfma_f32_16x16x32_bf16 v[168:171], v[48:51], v[144:147], 0
v_mfma_f32_16x16x32_bf16 v[172:175], v[64:67], v[144:147], 0
s_waitcnt lgkmcnt(2)
v_mfma_f32_16x16x32_bf16 v[160:163], v[20:23], v[148:151], v[160:163]
v_mfma_f32_16x16x32_bf16 v[164:167], v[36:39], v[148:151], v[164:167]
v_mfma_f32_16x16x32_bf16 v[168:171], v[52:55], v[148:151], v[168:171]
v_mfma_f32_16x16x32_bf16 v[172:175], v[68:71], v[148:151], v[172:175]
s_waitcnt lgkmcnt(1)
v_mfma_f32_16x16x32_bf16 v[160:163], v[24:27], v[152:155], v[160:163]
v_mfma_f32_16x16x32_bf16 v[164:167], v[40:43], v[152:155], v[164:167]
v_mfma_f32_16x16x32_bf16 v[168:171], v[56:59], v[152:155], v[168:171]
v_mfma_f32_16x16x32_bf16 v[172:175], v[72:75], v[152:155], v[172:175]
s_waitcnt lgkmcnt(0)
v_mfma_f32_16x16x32_bf16 v[160:163], v[28:31], v[156:159], v[160:163]
v_mfma_f32_16x16x32_bf16 v[164:167], v[44:47], v[156:159], v[164:167]
v_mfma_f32_16x16x32_bf16 v[168:171], v[60:63], v[156:159], v[168:171]
v_mfma_f32_16x16x32_bf16 v[172:175], v[76:79], v[156:159], v[172:175]
s_nop 4
v_max3_f32 v8, v160, v161, v162
v_max3_f32 v8, v8, v163, v164
v_max3_f32 v8, v8, v165, v166
v_max3_f32 v8, v8, v167, v168
v_max3_f32 v8, v8, v169, v170
v_max3_f32 v8, v8, v171, v172
v_max3_f32 v8, v8, v173, v174
v_max_f32 v8, v8, v175
v_mov_b32 v9, v8
s_nop 1
v_permlane16_swap_b32 v8, v9
v_max_f32 v8, v8, v9
v_mov_b32 v9, v8
s_nop 1
v_permlane32_swap_b32 v8, v9
v_max_f32 v8, v8, v9
v_mul_f32 v8, s36, v8
v_fma_f32 v160, v160, s36, -v8
v_fma_f32 v161, v161, s36, -v8
v_fma_f32 v162, v162, s36, -v8
v_fma_f32 v163, v163, s36, -v8
v_fma_f32 v164, v164, s36, -v8
v_fma_f32 v165, v165, s36, -v8
v_fma_f32 v166, v166, s36, -v8
v_fma_f32 v167, v167, s36, -v8
v_fma_f32 v168, v168, s36, -v8
v_fma_f32 v169, v169, s36, -v8
v_fma_f32 v170, v170, s36, -v8
v_fma_f32 v171, v171, s36, -v8
v_fma_f32 v172, v172, s36, -v8
v_fma_f32 v173, v173, s36, -v8
v_fma_f32 v174, v174, s36, -v8
v_fma_f32 v175, v175, s36, -v8
v_exp_f32 v160, v160
v_exp_f32 v161, v161
v_exp_f32 v162, v162
v_exp_f32 v163, v163
v_cvt_pk_bf16_f32 v144, v160, v161
v_exp_f32 v164, v164
v_exp_f32 v165, v165
v_cvt_pk_bf16_f32 v145, v162, v163
v_exp_f32 v166, v166
v_exp_f32 v167, v167
v_cvt_pk_bf16_f32 v146, v164, v165
v_exp_f32 v168, v168
v_exp_f32 v169, v169
v_cvt_pk_bf16_f32 v147, v166, v167
v_exp_f32 v170, v170
v_exp_f32 v171, v171
v_cvt_pk_bf16_f32 v148, v168, v169
v_exp_f32 v172, v172
v_exp_f32 v173, v173
v_cvt_pk_bf16_f32 v149, v170, v171
v_exp_f32 v174, v174
v_exp_f32 v175, v175
v_cvt_pk_bf16_f32 v150, v172, v173
s_nop 0
v_cvt_pk_bf16_f32 v151, v174, v175
v_mfma_f32_16x16x32_bf16 v[176:179], v[144:147], v[208:211], 0
v_pk_add_f32 v[152:153], v[160:161], v[162:163]
v_pk_add_f32 v[154:155], v[164:165], v[166:167]
v_mfma_f32_16x16x32_bf16 v[180:183], v[144:147], v[212:215], 0
v_pk_add_f32 v[156:157], v[168:169], v[170:171]
v_pk_add_f32 v[158:159], v[172:173], v[174:175]
v_mfma_f32_16x16x32_bf16 v[184:187], v[144:147], v[216:219], 0
v_pk_add_f32 v[152:153], v[152:153], v[154:155]
v_pk_add_f32 v[156:157], v[156:157], v[158:159]
v_mfma_f32_16x16x32_bf16 v[188:191], v[144:147], v[220:223], 0
v_pk_add_f32 v[152:153], v[152:153], v[156:157]
v_add_f32 v9, v152, v153
v_mfma_f32_16x16x32_bf16 v[192:195], v[144:147], v[224:227], 0
v_mov_b32 v15, v9
s_nop 1
v_mfma_f32_16x16x32_bf16 v[196:199], v[144:147], v[228:231], 0
v_permlane16_swap_b32 v9, v15
v_add_f32 v9, v9, v15
v_mfma_f32_16x16x32_bf16 v[200:203], v[144:147], v[232:235], 0
v_mov_b32 v15, v9
s_nop 1
v_mfma_f32_16x16x32_bf16 v[204:207], v[144:147], v[236:239], 0
v_permlane32_swap_b32 v9, v15
v_add_f32 v9, v9, v15
ds_write_b64 v10, v[8:9] offset:41984
s_waitcnt vmcnt(8)
v_perm_b32 v81, v124, v120, s37
v_perm_b32 v85, v124, v120, s38
v_perm_b32 v89, v125, v121, s37
v_perm_b32 v93, v125, v121, s38
v_perm_b32 v97, v126, v122, s37
v_perm_b32 v101, v126, v122, s38
v_perm_b32 v105, v127, v123, s37
v_perm_b32 v109, v127, v123, s38
s_waitcnt vmcnt(6)
v_perm_b32 v82, v132, v128, s37
v_perm_b32 v86, v132, v128, s38
v_perm_b32 v90, v133, v129, s37
v_perm_b32 v94, v133, v129, s38
v_perm_b32 v98, v134, v130, s37
v_perm_b32 v102, v134, v130, s38
v_perm_b32 v106, v135, v131, s37
v_perm_b32 v110, v135, v131, s38
s_waitcnt vmcnt(4)
v_perm_b32 v83, v140, v136, s37
v_perm_b32 v87, v140, v136, s38
v_perm_b32 v91, v141, v137, s37
v_mfma_f32_16x16x32_bf16 v[176:179], v[148:151], v[80:83], v[176:179]
v_perm_b32 v95, v141, v137, s38
v_mfma_f32_16x16x32_bf16 v[180:183], v[148:151], v[84:87], v[180:183]
v_perm_b32 v99, v142, v138, s37
v_mfma_f32_16x16x32_bf16 v[184:187], v[148:151], v[88:91], v[184:187]
v_perm_b32 v103, v142, v138, s38
v_mfma_f32_16x16x32_bf16 v[188:191], v[148:151], v[92:95], v[188:191]
v_perm_b32 v107, v143, v139, s37
v_mfma_f32_16x16x32_bf16 v[192:195], v[148:151], v[96:99], v[192:195]
v_perm_b32 v111, v143, v139, s38
v_mfma_f32_16x16x32_bf16 v[196:199], v[148:151], v[100:103], v[196:199]
v_mfma_f32_16x16x32_bf16 v[200:203], v[148:151], v[104:107], v[200:203]
v_mfma_f32_16x16x32_bf16 v[204:207], v[148:151], v[108:111], v[204:207]
s_nop 3
ds_write2st64_b32 v240, v176, v180 offset0:0 offset1:1
ds_write2st64_b32 v241, v184, v188 offset0:2 offset1:3
ds_write2st64_b32 v242, v192, v196 offset0:4 offset1:5
s_nop 0
ds_write2st64_b32 v243, v200, v204 offset0:6 offset1:7
s_waitcnt lgkmcnt(0)
s_barrier
s_mov_b32 s50, 20000
s_waitcnt vmcnt(0)
s_barrier
global_load_dwordx4 v[16:19], v4, s[46:47] sc1
global_load_dwordx4 v[20:23], v4, s[46:47] offset:1024 sc1
ds_read_b64_tr_b16 v[80:81], v11 offset:16384
ds_read_b64_tr_b16 v[82:83], v11 offset:18432
ds_read_b64_tr_b16 v[84:85], v11 offset:16896
ds_read_b64_tr_b16 v[86:87], v11 offset:18944
ds_read_b64_tr_b16 v[88:89], v11 offset:24576
ds_read_b64_tr_b16 v[90:91], v11 offset:26624
ds_read_b64_tr_b16 v[92:93], v11 offset:25088
ds_read_b64_tr_b16 v[94:95], v11 offset:27136
L_poll1:
s_waitcnt vmcnt(0)
v_max3_u32 v36, v16, v17, v18
v_max3_u32 v37, v20, v21, v22
v_max3_u32 v36, v36, v19, v23
v_max_u32 v36, v36, v37
v_cmp_eq_u32 vcc, -1, v36
s_cbranch_vccz L_poll1_done
global_load_dwordx4 v[16:19], v4, s[46:47] sc1
global_load_dwordx4 v[20:23], v4, s[46:47] offset:1024 sc1
s_sub_u32 s50, s50, 1
s_cbranch_scc0 L_poll1
s_waitcnt vmcnt(0)
L_poll1_done:
ds_write_b128 v245, v[16:19] offset:0
ds_write_b128 v246, v[20:23] offset:1024
s_waitcnt lgkmcnt(0)
s_barrier
ds_read_b128 v[40:43], v247 offset:0
ds_read_b128 v[44:47], v247 offset:512
ds_read_b128 v[48:51], v248 offset:0
ds_read_b128 v[52:55], v248 offset:512
ds_read_b128 v[56:59], v249 offset:0
ds_read_b128 v[60:63], v249 offset:512
ds_read_b128 v[64:67], v250 offset:0
ds_read_b128 v[68:71], v250 offset:512
ds_read2_b32 v[32:33], v244 offset0:0 offset1:0
ds_read2_b32 v[34:35], v244 offset0:2 offset1:2
s_waitcnt lgkmcnt(9)
v_mfma_f32_16x16x32_bf16 v[112:115], v[80:83], v[40:43], 0
s_waitcnt lgkmcnt(8)
v_mfma_f32_16x16x32_bf16 v[116:119], v[80:83], v[44:47], 0
s_waitcnt lgkmcnt(7)
v_mfma_f32_16x16x32_bf16 v[112:115], v[84:87], v[48:51], v[112:115]
s_waitcnt lgkmcnt(6)
v_mfma_f32_16x16x32_bf16 v[116:119], v[84:87], v[52:55], v[116:119]
s_waitcnt lgkmcnt(5)
v_mfma_f32_16x16x32_bf16 v[112:115], v[88:91], v[56:59], v[112:115]
s_waitcnt lgkmcnt(4)
v_mfma_f32_16x16x32_bf16 v[116:119], v[88:91], v[60:63], v[116:119]
s_waitcnt lgkmcnt(3)
v_mfma_f32_16x16x32_bf16 v[112:115], v[92:95], v[64:67], v[112:115]
s_waitcnt lgkmcnt(2)
v_mfma_f32_16x16x32_bf16 v[116:119], v[92:95], v[68:71], v[116:119]
s_waitcnt lgkmcnt(0)
s_nop 4
v_pk_mul_f32 v[112:113], v[112:113], v[32:33]
v_pk_mul_f32 v[114:115], v[114:115], v[32:33]
v_pk_fma_f32 v[112:113], v[116:117], v[34:35], v[112:113]
v_pk_fma_f32 v[114:115], v[118:119], v[34:35], v[114:115]
s_nop 0
v_add_f32_dpp v24, v112, v112 row_ror:8 row_mask:0xf bank_mask:0xf
v_add_f32_dpp v25, v113, v113 row_ror:8 row_mask:0xf bank_mask:0xf
v_add_f32_dpp v26, v114, v114 row_ror:8 row_mask:0xf bank_mask:0xf
v_add_f32_dpp v27, v115, v115 row_ror:8 row_mask:0xf bank_mask:0xf
v_bfi_b32 v24, s42, v252, v24
v_bfi_b32 v25, s42, v253, v25
v_bfi_b32 v26, s42, v254, v26
v_bfi_b32 v27, s42, v255, v27
s_mov_b64 exec, s[44:45]
global_store_dwordx4 v14, v[24:27], s[48:49] sc1
s_waitcnt vmcnt(0)
s_barrier
s_endpgm
L_sync:
s_lshl_b32 s29, s27, 8
v_and_b32 v3, 7, v1
v_lshrrev_b32 v7, 3, v1
v_lshlrev_b32 v4, 10, v3
v_lshl_add_u32 v4, v7, 6, v4
v_lshl_add_u32 v4, v2, 4, v4
v_lshlrev_b32 v8, 4, v0
s_getpc_b64 s[46:47]
L_pc:
s_lshl_b32 s50, s28, 10
s_sub_u32 s46, s46, L_pc-standalone__sliding_block_cached__decode_kernel
s_subb_u32 s47, s47, 0
s_add_u32 s46, s46, s50
s_addc_u32 s47, s47, 0
global_load_dwordx4 v[120:123], v8, s[46:47]
v_lshlrev_b32 v14, 13, v2
v_lshl_add_u32 v14, v1, 4, v14
s_lshl_b32 s44, s20, 15
s_lshl_b32 s45, s21, 8
s_add_u32 s44, s44, s45
s_add_u32 s44, s44, 262144
v_mov_b32 v10, -1
v_mov_b32 v11, -1
v_mov_b32 v12, -1
v_mov_b32 v13, -1
v_mov_b32 v125, 0
s_waitcnt lgkmcnt(0)
s_add_u32 s4, s4, s29
s_addc_u32 s5, s5, 0
global_load_dwordx4 v[16:19], v4, s[4:5] offset:0
global_load_dwordx4 v[20:23], v4, s[4:5] offset:128
s_load_dword s25, s[18:19], 0
s_add_u32 s44, s18, s44
s_addc_u32 s45, s19, 0
global_store_dwordx4 v14, v[10:13], s[44:45]
global_load_dword v127, v125, s[14:15]
s_setprio 3
v_lshlrev_b32 v9, 3, v0
v_lshlrev_b32 v15, 2, v0
ds_write_b32 v15, v10 offset:41984
v_lshrrev_b32 v6, 2, v1
v_lshl_add_u32 v6, v2, 3, v6
v_lshlrev_b32 v6, 7, v6
v_and_b32 v5, 3, v1
v_lshl_add_u32 v6, v5, 3, v6
v_lshlrev_b32 v124, 13, v3
v_lshl_add_u32 v124, v7, 6, v124
v_lshl_add_u32 v124, v2, 4, v124
s_lshl_b32 s26, s20, 16
s_lshl_b32 s29, s27, 11
s_add_u32 s29, s29, s26
s_lshl_b32 s30, s28, 8
s_add_u32 s29, s29, s30
s_add_u32 s29, s29, 524288
s_add_u32 s32, s18, s29
s_addc_u32 s33, s19, 0
s_lshl_b32 s29, s22, 13
s_add_u32 s29, s29, s26
s_add_u32 s29, s29, 524288
s_add_u32 s34, s18, s29
s_addc_u32 s35, s19, 0
s_add_u32 s42, s34, 4096
s_addc_u32 s43, s35, 0
s_getreg_b32 s59, hwreg(HW_REG_XCC_ID, 0, 4)
v_lshlrev_b32 v104, 3, v2
v_lshlrev_b32 v105, 5, v2
s_lshl_b32 s29, s20, 12
s_lshl_b32 s30, s21, 7
s_add_u32 s30, s30, s29
s_add_u32 s30, s30, 32768
s_add_u32 s36, s18, s30
s_addc_u32 s37, s19, 0
v_and_b32 v106, 31, v0
v_lshlrev_b32 v106, 7, v106
s_lshl_b32 s30, s27, 3
s_add_u32 s29, s29, s30
s_add_u32 s29, s29, 32768
s_add_u32 s38, s18, s29
s_addc_u32 s39, s19, 0
s_lshl_b32 s46, s20, 4
s_lshr_b32 s47, s21, 1
s_add_u32 s46, s46, s47
s_and_b32 s29, s21, 1
s_lshl_b32 s47, s46, 3
s_lshl_b32 s48, s29, 12
s_add_u32 s47, s47, s48
s_lshl_b32 s46, s46, 12
s_lshl_b32 s48, s29, 6
s_add_u32 s46, s46, s48
s_add_u32 s46, s46, 1048576
s_add_u32 s48, s18, s46
s_addc_u32 s49, s19, 0
s_add_u32 s46, s14, s47
s_addc_u32 s47, s15, 0
v_lshrrev_b32 v107, 2, v0
v_lshlrev_b32 v107, 7, v107
v_lshl_add_u32 v107, v5, 4, v107
v_lshlrev_b32 v108, 10, v5
v_bfe_u32 v5, v0, 2, 2
v_lshl_add_u32 v108, v5, 1, v108
v_bfe_u32 v109, v0, 1, 2
v_and_b32 v5, 0x39, v0
v_and_b32 v110, 1, v0
v_mul_u32_u24 v110, 3, v110
v_add_u32 v5, v5, v110
v_lshl_add_u32 v5, v109, 4, v5
v_and_b32 v5, 63, v5
v_lshlrev_b32 v5, 2, v5
v_lshl_add_u32 v109, v109, 9, v5
s_mov_b32 s30, 0x00010001
s_mov_b32 s31, 0x00010001
s_waitcnt lgkmcnt(0)
s_add_u32 s51, s25, 1
s_mul_i32 s25, s25, 0x9E3779B1
s_add_u32 s25, s25, 0x7F4A7C15
s_andn2_b32 s25, s25, 0xff
s_and_b32 s56, s51, 0xff
s_or_b32 s25, s25, s56
s_lshr_b32 s56, s25, 8
s_lshr_b32 s57, s25, 16
s_lshr_b32 s58, s25, 24
s_andn2_b32 s40, s58, 15
s_or_b32 s40, s40, s59
v_mov_b32 v116, s25
v_mov_b32 v117, s56
v_mov_b32 v118, s57
v_mov_b32 v119, s40
v_mov_b32 v113, s25
s_movk_i32 s26, 0xff
s_movk_i32 s41, 0xff00
s_barrier
ds_read_b64_tr_b16 v[24:25], v6 offset:0
ds_read_b64_tr_b16 v[26:27], v6 offset:512
ds_read_b64_tr_b16 v[28:29], v6 offset:32
ds_read_b64_tr_b16 v[30:31], v6 offset:544
ds_read_b64_tr_b16 v[32:33], v6 offset:64
ds_read_b64_tr_b16 v[34:35], v6 offset:576
ds_read_b64_tr_b16 v[36:37], v6 offset:96
ds_read_b64_tr_b16 v[38:39], v6 offset:608
s_waitcnt lgkmcnt(4)
ds_read_b64_tr_b16 v[40:41], v6 offset:4096
ds_read_b64_tr_b16 v[42:43], v6 offset:4608
ds_read_b64_tr_b16 v[44:45], v6 offset:4128
ds_read_b64_tr_b16 v[46:47], v6 offset:4640
ds_read_b64_tr_b16 v[48:49], v6 offset:4160
ds_read_b64_tr_b16 v[50:51], v6 offset:4672
ds_read_b64_tr_b16 v[52:53], v6 offset:4192
ds_read_b64_tr_b16 v[54:55], v6 offset:4704
s_waitcnt vmcnt(1)
s_waitcnt lgkmcnt(8)
v_mfma_f32_16x16x32_bf16 v[64:67], v[24:27], v[16:19], 0
v_mfma_f32_16x16x32_bf16 v[72:75], v[28:31], v[16:19], 0
v_mfma_f32_16x16x32_bf16 v[80:83], v[32:35], v[16:19], 0
v_mfma_f32_16x16x32_bf16 v[88:91], v[36:39], v[16:19], 0
s_waitcnt lgkmcnt(4)
ds_read_b64_tr_b16 v[24:25], v6 offset:8192
ds_read_b64_tr_b16 v[26:27], v6 offset:8704
ds_read_b64_tr_b16 v[28:29], v6 offset:8224
ds_read_b64_tr_b16 v[30:31], v6 offset:8736
ds_read_b64_tr_b16 v[32:33], v6 offset:8256
ds_read_b64_tr_b16 v[34:35], v6 offset:8768
ds_read_b64_tr_b16 v[36:37], v6 offset:8288
ds_read_b64_tr_b16 v[38:39], v6 offset:8800
s_waitcnt lgkmcnt(8)
v_mfma_f32_16x16x32_bf16 v[68:71], v[40:43], v[16:19], 0
v_mfma_f32_16x16x32_bf16 v[76:79], v[44:47], v[16:19], 0
v_mfma_f32_16x16x32_bf16 v[84:87], v[48:51], v[16:19], 0
v_mfma_f32_16x16x32_bf16 v[92:95], v[52:55], v[16:19], 0
s_waitcnt lgkmcnt(4)
ds_read_b64_tr_b16 v[40:41], v6 offset:12288
ds_read_b64_tr_b16 v[42:43], v6 offset:12800
ds_read_b64_tr_b16 v[44:45], v6 offset:12320
ds_read_b64_tr_b16 v[46:47], v6 offset:12832
ds_read_b64_tr_b16 v[48:49], v6 offset:12352
ds_read_b64_tr_b16 v[50:51], v6 offset:12864
ds_read_b64_tr_b16 v[52:53], v6 offset:12384
ds_read_b64_tr_b16 v[54:55], v6 offset:12896
s_waitcnt lgkmcnt(8)
v_mfma_f32_16x16x32_bf16 v[64:67], v[24:27], v[20:23], v[64:67]
v_mfma_f32_16x16x32_bf16 v[72:75], v[28:31], v[20:23], v[72:75]
v_mfma_f32_16x16x32_bf16 v[80:83], v[32:35], v[20:23], v[80:83]
v_mfma_f32_16x16x32_bf16 v[88:91], v[36:39], v[20:23], v[88:91]
s_waitcnt lgkmcnt(0)
v_mfma_f32_16x16x32_bf16 v[68:71], v[40:43], v[20:23], v[68:71]
v_mfma_f32_16x16x32_bf16 v[76:79], v[44:47], v[20:23], v[76:79]
v_mfma_f32_16x16x32_bf16 v[84:87], v[48:51], v[20:23], v[84:87]
v_mfma_f32_16x16x32_bf16 v[92:95], v[52:55], v[20:23], v[92:95]
s_nop 4
v_add_f32_dpp v96, v68, v64 row_ror:8 row_mask:0xf bank_mask:0x3
v_add_f32_dpp v97, v69, v65 row_ror:8 row_mask:0xf bank_mask:0x3
v_add_f32_dpp v98, v70, v66 row_ror:8 row_mask:0xf bank_mask:0x3
v_add_f32_dpp v99, v71, v67 row_ror:8 row_mask:0xf bank_mask:0x3
v_add_f32_dpp v96, v72, v76 row_ror:8 row_mask:0xf bank_mask:0xc
v_add_f32_dpp v97, v73, v77 row_ror:8 row_mask:0xf bank_mask:0xc
v_add_f32_dpp v98, v74, v78 row_ror:8 row_mask:0xf bank_mask:0xc
v_add_f32_dpp v99, v75, v79 row_ror:8 row_mask:0xf bank_mask:0xc
v_bfi_b32 v96, s26, v116, v96
v_bfi_b32 v97, s26, v117, v97
v_bfi_b32 v98, s26, v118, v98
v_bfi_b32 v99, s26, v119, v99
global_store_dwordx4 v124, v[96:99], s[32:33] offset:0
v_add_f32_dpp v100, v84, v80 row_ror:8 row_mask:0xf bank_mask:0x3
v_add_f32_dpp v101, v85, v81 row_ror:8 row_mask:0xf bank_mask:0x3
v_add_f32_dpp v102, v86, v82 row_ror:8 row_mask:0xf bank_mask:0x3
v_add_f32_dpp v103, v87, v83 row_ror:8 row_mask:0xf bank_mask:0x3
v_add_f32_dpp v100, v88, v92 row_ror:8 row_mask:0xf bank_mask:0xc
v_add_f32_dpp v101, v89, v93 row_ror:8 row_mask:0xf bank_mask:0xc
v_add_f32_dpp v102, v90, v94 row_ror:8 row_mask:0xf bank_mask:0xc
v_add_f32_dpp v103, v91, v95 row_ror:8 row_mask:0xf bank_mask:0xc
v_bfi_b32 v100, s26, v116, v100
v_bfi_b32 v101, s26, v117, v101
v_bfi_b32 v102, s26, v118, v102
v_bfi_b32 v103, s26, v119, v103
global_store_dwordx4 v124, v[100:103], s[32:33] offset:128
s_barrier
s_mov_b32 s50, 0
L_pollq:
global_load_dwordx4 v[16:19], v8, s[34:35] offset:0 nt
global_load_dwordx4 v[20:23], v8, s[34:35] offset:1024 nt
global_load_dwordx4 v[24:27], v8, s[34:35] offset:2048 nt
global_load_dwordx4 v[28:31], v8, s[34:35] offset:3072 nt
global_load_dwordx4 v[32:35], v8, s[42:43] offset:0 nt
global_load_dwordx4 v[36:39], v8, s[42:43] offset:1024 nt
global_load_dwordx4 v[40:43], v8, s[42:43] offset:2048 nt
global_load_dwordx4 v[44:47], v8, s[42:43] offset:3072 nt
L_pollq_c:
v_mov_b32 v64, 0
v_mov_b32 v65, 0
s_waitcnt vmcnt(7)
v_bitop3_b32 v64, v64, v16, s25 bitop3:0xf6
v_bitop3_b32 v64, v64, v17, s56 bitop3:0xf6
v_bitop3_b32 v64, v64, v18, s57 bitop3:0xf6
v_bitop3_b32 v65, v65, v19, s40 bitop3:0xf6
v_and_b32 v16, s41, v16
v_and_b32 v17, s41, v17
v_and_b32 v18, s41, v18
v_and_b32 v19, s41, v19
s_waitcnt vmcnt(6)
v_bitop3_b32 v64, v64, v20, s25 bitop3:0xf6
v_bitop3_b32 v64, v64, v21, s56 bitop3:0xf6
v_bitop3_b32 v64, v64, v22, s57 bitop3:0xf6
v_bitop3_b32 v65, v65, v23, s40 bitop3:0xf6
v_and_b32 v20, s41, v20
v_and_b32 v21, s41, v21
v_and_b32 v22, s41, v22
v_and_b32 v23, s41, v23
s_waitcnt vmcnt(5)
v_bitop3_b32 v64, v64, v24, s25 bitop3:0xf6
v_bitop3_b32 v64, v64, v25, s56 bitop3:0xf6
v_bitop3_b32 v64, v64, v26, s57 bitop3:0xf6
v_bitop3_b32 v65, v65, v27, s40 bitop3:0xf6
v_and_b32 v24, s41, v24
v_and_b32 v25, s41, v25
v_and_b32 v26, s41, v26
v_and_b32 v27, s41, v27
s_waitcnt vmcnt(4)
v_bitop3_b32 v64, v64, v28, s25 bitop3:0xf6
v_bitop3_b32 v64, v64, v29, s56 bitop3:0xf6
v_bitop3_b32 v64, v64, v30, s57 bitop3:0xf6
v_bitop3_b32 v65, v65, v31, s40 bitop3:0xf6
v_and_b32 v28, s41, v28
v_and_b32 v29, s41, v29
v_and_b32 v30, s41, v30
v_and_b32 v31, s41, v31
s_waitcnt vmcnt(3)
v_bitop3_b32 v64, v64, v32, s25 bitop3:0xf6
v_bitop3_b32 v64, v64, v33, s56 bitop3:0xf6
v_bitop3_b32 v64, v64, v34, s57 bitop3:0xf6
v_bitop3_b32 v65, v65, v35, s40 bitop3:0xf6
v_and_b32 v32, s41, v32
v_and_b32 v33, s41, v33
v_and_b32 v34, s41, v34
v_and_b32 v35, s41, v35
s_waitcnt vmcnt(2)
v_bitop3_b32 v64, v64, v36, s25 bitop3:0xf6
v_bitop3_b32 v64, v64, v37, s56 bitop3:0xf6
v_bitop3_b32 v64, v64, v38, s57 bitop3:0xf6
v_bitop3_b32 v65, v65, v39, s40 bitop3:0xf6
v_and_b32 v36, s41, v36
v_and_b32 v37, s41, v37
v_and_b32 v38, s41, v38
v_and_b32 v39, s41, v39
s_waitcnt vmcnt(1)
v_bitop3_b32 v64, v64, v40, s25 bitop3:0xf6
v_bitop3_b32 v64, v64, v41, s56 bitop3:0xf6
v_bitop3_b32 v64, v64, v42, s57 bitop3:0xf6
v_bitop3_b32 v65, v65, v43, s40 bitop3:0xf6
v_and_b32 v40, s41, v40
v_and_b32 v41, s41, v41
v_and_b32 v42, s41, v42
v_and_b32 v43, s41, v43
s_waitcnt vmcnt(0)
v_bitop3_b32 v64, v64, v44, s25 bitop3:0xf6
v_bitop3_b32 v64, v64, v45, s56 bitop3:0xf6
v_bitop3_b32 v64, v64, v46, s57 bitop3:0xf6
v_bitop3_b32 v65, v65, v47, s40 bitop3:0xf6
v_and_b32 v44, s41, v44
v_and_b32 v45, s41, v45
v_and_b32 v46, s41, v46
v_and_b32 v47, s41, v47
v_and_b32 v66, 0xf0, v65
v_and_or_b32 v64, v64, s26, v66
v_cmp_ne_u32 vcc, 0, v64
s_cbranch_vccz L_pollq_done
s_add_u32 s50, s50, 1
s_cmp_lt_u32 s50, 2
s_cbranch_scc1 L_pollq
s_cmp_lt_u32 s50, 20000
s_cbranch_scc1 L_pollq_slow
L_pollq_done:
v_pk_add_f32 v[16:17], v[16:17], v[24:25]
v_pk_add_f32 v[32:33], v[32:33], v[40:41]
v_pk_add_f32 v[18:19], v[18:19], v[26:27]
v_pk_add_f32 v[34:35], v[34:35], v[42:43]
v_pk_add_f32 v[20:21], v[20:21], v[28:29]
v_pk_add_f32 v[36:37], v[36:37], v[44:45]
v_pk_add_f32 v[22:23], v[22:23], v[30:31]
v_pk_add_f32 v[38:39], v[38:39], v[46:47]
v_pk_add_f32 v[16:17], v[16:17], v[32:33]
v_pk_add_f32 v[18:19], v[18:19], v[34:35]
v_pk_add_f32 v[20:21], v[20:21], v[36:37]
v_pk_add_f32 v[22:23], v[22:23], v[38:39]
v_cvt_pk_bf16_f32 v66, v16, v17
v_cvt_pk_bf16_f32 v67, v18, v19
ds_write_b64 v9, v[66:67] offset:40960
v_cvt_pk_bf16_f32 v68, v20, v21
v_cvt_pk_bf16_f32 v69, v22, v23
ds_write_b64 v9, v[68:69] offset:41472
s_waitcnt lgkmcnt(0)
s_barrier
v_and_b32 v65, 15, v65
v_cmp_ne_u32 s[54:55], 0, v65
s_mov_b32 s50, 160000
s_cmp_eq_u64 s[54:55], 0
s_cbranch_scc0 L_notloc
L_sspin:
ds_read_b128 v[16:19], v105 offset:41984
ds_read_b128 v[20:23], v105 offset:42000
s_waitcnt lgkmcnt(0)
v_max3_u32 v24, v17, v19, v21
v_max_u32 v24, v24, v23
v_cmp_eq_u32 vcc, -1, v24
s_cbranch_vccz L_sspin_done
s_sub_u32 s50, s50, 1
s_cbranch_scc0 L_sspin
L_sspin_done:
v_max3_f32 v24, v16, v18, v20
v_max_f32 v24, v24, v22
v_sub_f32 v16, v16, v24
v_sub_f32 v18, v18, v24
v_sub_f32 v20, v20, v24
v_sub_f32 v22, v22, v24
v_exp_f32 v16, v16
v_exp_f32 v18, v18
v_exp_f32 v20, v20
v_exp_f32 v22, v22
s_nop 0
v_mul_f32 v25, v16, v17
v_fmac_f32 v25, v18, v19
v_fmac_f32 v25, v20, v21
v_fmac_f32 v25, v22, v23
v_log_f32 v26, v25
v_rcp_f32 v25, v25
v_add_f32 v112, v24, v26
s_mov_b64 exec, s[30:31]
s_cmp_eq_u64 s[54:55], 0
s_cbranch_scc0 L_st_glob
global_store_dwordx2 v104, v[112:113], s[36:37]
L_st_done:
s_mov_b64 exec, -1
global_load_dwordx2 v[80:81], v106, s[38:39] sc1
v_mul_f32 v16, v16, v25
v_mul_f32 v18, v18, v25
v_mul_f32 v20, v20, v25
v_mul_f32 v22, v22, v25
v_mov_b32 v17, v16
v_mov_b32 v19, v18
v_mov_b32 v21, v20
v_mov_b32 v23, v22
s_cmp_eq_u64 s[54:55], 0
s_barrier
ds_read_b128 v[32:35], v109 offset:32768
ds_read_b128 v[36:39], v109 offset:33024
ds_read_b128 v[40:43], v109 offset:34816
ds_read_b128 v[44:47], v109 offset:35072
ds_read_b128 v[48:51], v109 offset:36864
ds_read_b128 v[52:55], v109 offset:37120
ds_read_b128 v[56:59], v109 offset:38912
ds_read_b128 v[60:63], v109 offset:39168
s_waitcnt lgkmcnt(6)
v_pk_mul_f32 v[32:33], v[32:33], v[16:17]
v_pk_mul_f32 v[34:35], v[34:35], v[16:17]
v_pk_mul_f32 v[36:37], v[36:37], v[16:17]
v_pk_mul_f32 v[38:39], v[38:39], v[16:17]
s_waitcnt lgkmcnt(4)
v_pk_fma_f32 v[32:33], v[40:41], v[18:19], v[32:33]
v_pk_fma_f32 v[34:35], v[42:43], v[18:19], v[34:35]
v_pk_fma_f32 v[36:37], v[44:45], v[18:19], v[36:37]
v_pk_fma_f32 v[38:39], v[46:47], v[18:19], v[38:39]
s_waitcnt lgkmcnt(2)
v_pk_fma_f32 v[32:33], v[48:49], v[20:21], v[32:33]
v_pk_fma_f32 v[34:35], v[50:51], v[20:21], v[34:35]
v_pk_fma_f32 v[36:37], v[52:53], v[20:21], v[36:37]
v_pk_fma_f32 v[38:39], v[54:55], v[20:21], v[38:39]
s_waitcnt lgkmcnt(0)
v_pk_fma_f32 v[32:33], v[56:57], v[22:23], v[32:33]
v_pk_fma_f32 v[34:35], v[58:59], v[22:23], v[34:35]
v_pk_fma_f32 v[36:37], v[60:61], v[22:23], v[36:37]
v_pk_fma_f32 v[38:39], v[62:63], v[22:23], v[38:39]
v_cvt_pk_bf16_f32 v116, v32, v36
v_cvt_pk_bf16_f32 v117, v33, v37
v_cvt_pk_bf16_f32 v118, v34, v38
v_cvt_pk_bf16_f32 v119, v35, v39
s_cbranch_scc0 L_o_glob
global_store_dwordx4 v14, v[116:119], s[44:45]
s_barrier
L_polls0:
s_mov_b32 s50, 20000
s_waitcnt vmcnt(1)
L_polls:
v_cmp_ne_u32 vcc, s25, v81
s_cbranch_vccz L_polls_done
global_load_dwordx2 v[80:81], v106, s[38:39] sc1
s_waitcnt vmcnt(0)
s_sub_u32 s50, s50, 1
s_cbranch_scc0 L_polls
L_polls_done:
v_max_f32_dpp v82, v80, v80 quad_perm:[1,0,3,2] row_mask:0xf bank_mask:0xf
s_nop 1
v_max_f32_dpp v82, v82, v82 quad_perm:[2,3,0,1] row_mask:0xf bank_mask:0xf
v_sub_f32 v80, v80, v82
v_exp_f32 v80, v80
s_nop 1
v_add_f32_dpp v82, v80, v80 quad_perm:[1,0,3,2] row_mask:0xf bank_mask:0xf
s_nop 1
v_add_f32_dpp v82, v82, v82 quad_perm:[2,3,0,1] row_mask:0xf bank_mask:0xf
v_rcp_f32 v82, v82
s_nop 0
v_mul_f32 v80, v80, v82
ds_write_b32 v15, v80 offset:42112
s_waitcnt lgkmcnt(0)
s_cmp_eq_u64 s[54:55], 0
s_cbranch_scc1 L_d0_done
s_barrier
L_d0_done:
s_mov_b32 s50, 20000
s_barrier
s_barrier
L_poll2:
global_load_dwordx4 v[32:35], v107, s[48:49] offset:0 sc1
global_load_dwordx4 v[36:39], v107, s[48:49] offset:2048 sc1
s_waitcnt vmcnt(1)
v_xor_b32 v26, s25, v32
v_xor_b32 v27, s56, v33
v_bitop3_b32 v26, v26, v34, s57 bitop3:0xf6
v_bitop3_b32 v27, v27, v35, s58 bitop3:0xf6
v_and_b32 v32, s41, v32
v_and_b32 v33, s41, v33
v_and_b32 v34, s41, v34
v_and_b32 v35, s41, v35
s_waitcnt vmcnt(0)
v_bitop3_b32 v26, v26, v36, s25 bitop3:0xf6
v_bitop3_b32 v27, v27, v37, s56 bitop3:0xf6
v_bitop3_b32 v26, v26, v38, s57 bitop3:0xf6
v_bitop3_b32 v27, v27, v39, s58 bitop3:0xf6
v_and_b32 v36, s41, v36
v_and_b32 v37, s41, v37
v_and_b32 v38, s41, v38
v_and_b32 v39, s41, v39
v_pk_add_f32 v[16:17], v[32:33], v[36:37]
v_pk_add_f32 v[18:19], v[34:35], v[38:39]
v_bitop3_b32 v26, v26, v27, s26 bitop3:0xa8
v_cmp_ne_u32 vcc, 0, v26
s_cbranch_vccz L_poll2_done
s_sub_u32 s50, s50, 1
s_cbranch_scc0 L_poll2
L_poll2_done:
v_add_f32_dpp v20, v16, v16 row_ror:8 row_mask:0xf bank_mask:0x3
v_add_f32_dpp v21, v17, v17 row_ror:8 row_mask:0xf bank_mask:0x3
v_add_f32_dpp v20, v18, v18 row_ror:8 row_mask:0xf bank_mask:0xc
v_add_f32_dpp v21, v19, v19 row_ror:8 row_mask:0xf bank_mask:0xc
s_nop 1
v_add_f32_dpp v22, v20, v20 row_shl:4 row_mask:0xf bank_mask:0x5
v_add_f32_dpp v22, v21, v21 row_shr:4 row_mask:0xf bank_mask:0xa
v_mov_b32 v23, v22
s_nop 1
v_permlane16_swap_b32 v22, v23
v_add_f32 v22, v22, v23
v_mov_b32 v23, v22
s_nop 1
v_permlane32_swap_b32 v22, v23
v_add_f32 v22, v22, v23
v_cvt_pk_bf16_f32 v22, v22, v22
s_mov_b64 exec, 0xffff
global_store_short v108, v22, s[46:47]
s_cmp_lg_u32 s2, 0
s_cbranch_scc1 L_noepoch
v_mov_b32 v16, s51
s_mov_b64 exec, 1
global_store_dword v125, v16, s[18:19]
L_noepoch:
L_end:
s_endpgm
L_pollq_slow:
s_cmp_lg_u32 s50, 2
s_cbranch_scc1 L_pollq_s2
global_store_dwordx4 v124, v[96:99], s[32:33] offset:0 sc1
global_store_dwordx4 v124, v[100:103], s[32:33] offset:128 sc1
L_pollq_s2:
global_load_dwordx4 v[16:19], v8, s[34:35] offset:0 sc1
global_load_dwordx4 v[20:23], v8, s[34:35] offset:1024 sc1
global_load_dwordx4 v[24:27], v8, s[34:35] offset:2048 sc1
global_load_dwordx4 v[28:31], v8, s[34:35] offset:3072 sc1
global_load_dwordx4 v[32:35], v8, s[42:43] offset:0 sc1
global_load_dwordx4 v[36:39], v8, s[42:43] offset:1024 sc1
global_load_dwordx4 v[40:43], v8, s[42:43] offset:2048 sc1
global_load_dwordx4 v[44:47], v8, s[42:43] offset:3072 sc1
s_branch L_pollq_c
L_notloc:
global_store_dwordx4 v124, v[96:99], s[32:33] offset:0 sc1
global_store_dwordx4 v124, v[100:103], s[32:33] offset:128 sc1
global_store_dwordx4 v14, v[10:13], s[44:45] sc1
s_branch L_sspin
L_o_glob:
global_store_dwordx4 v14, v[116:119], s[44:45] sc1
s_branch L_polls0
L_st_glob:
s_waitcnt vmcnt(0)
global_store_dwordx2 v104, v[112:113], s[36:37] sc1
s_branch L_st_done
.fill 384, 4, 0xBF800000
.section .rodata,"a"
.p2align 6
.amdhsa_kernel standalone__sliding_block_cached__decode_kernel
  .amdhsa_next_free_vgpr 256
  .amdhsa_next_free_sgpr 96
  .amdhsa_accum_offset 256
  .amdhsa_group_segment_fixed_size 0
  .amdhsa_kernarg_size 64
  .amdhsa_user_sgpr_count 2
  .amdhsa_user_sgpr_kernarg_segment_ptr 1
  .amdhsa_system_sgpr_workgroup_id_x 1
.end_amdhsa_kernel
```
